```python
import torch

def _softmax(x, axis=-1):
    return torch.softmax(x, dim=axis)
def _gelu(x):
    return torch.nn.functional.gelu(x, approximate="tanh")
def _silu(x):
    return torch.nn.functional.silu(x)
def _sigmoid(x):
    return torch.sigmoid(x)
def _layernorm(x, axis=-1, eps=1e-5):
    m = x.mean(dim=axis, keepdim=True)
    v = x.var(dim=axis, keepdim=True, unbiased=False)
    return (x - m) / torch.sqrt(v + eps)
def _scatter_add(tgt, idx, src, axis=0):
    return tgt.clone().index_add_(axis, idx, src)
def _segment_sum(src, seg, n):
    out = torch.zeros((n,) + src.shape[1:], dtype=src.dtype)
    return out.index_add_(0, seg, src)
def _pad(x, pw):
    flat = tuple(v for pair in reversed(pw) for v in pair)
    return torch.nn.functional.pad(x, flat)

kernel_name = 'parallel_sum__sliding_block_cached__dense_activation_silu__decode'

def setup_inputs():

    _w = (lambda a: (lambda t: t.to(torch.bfloat16) if t.is_floating_point() else t)(torch.as_tensor(a)))
    def _A_setup():
        B, Sq, D = 1, 1, 1024
        Hq, Hkv, Sk, Dh = 32, 4, 65536, 128
        assert Hq % Hkv == 0, (Hq, Hkv)
        return {
            "x": _w((lambda *s: torch.randn(*s, dtype=torch.bfloat16) * 0.05)(B, Sq, D)),
            "k_cache": _w((lambda *s: torch.randn(*s, dtype=torch.bfloat16) * 3.2)(B, Hkv, Sk, Dh)),
            "v_cache": _w((lambda *s: torch.randn(*s, dtype=torch.bfloat16) * 0.8)(B, Hkv, Sk, Dh)),
            "wq": _w((lambda *s: torch.randn(*s, dtype=torch.bfloat16) * 3.2)(D, Hq * Dh) * (D ** -0.5)),
            "wo": _w((lambda *s: torch.randn(*s, dtype=torch.bfloat16) * 0.8)(Hq * Dh, D) * ((Hq * Dh) ** -0.5)),
        }
    _A_in = _A_setup()

    def _B_setup():
        B, S, D, F = 1, 1, 1024, 3584
        return {
            "x": _w((lambda *s: torch.randn(*s, dtype=torch.bfloat16) * 0.05)(B, S, D)),
            "w1": _w((lambda *s: torch.randn(*s, dtype=torch.bfloat16) * 3.2)(D, F) * (D ** -0.5)),
            "w2": _w((lambda *s: torch.randn(*s, dtype=torch.bfloat16) * 0.2)(F, D) * (F ** -0.5)),
        }
    _B_in = _B_setup()

    return {
        "A_x": _A_in["x"],
        "A_k_cache": _A_in["k_cache"],
        "A_v_cache": _A_in["v_cache"],
        "A_wq": _A_in["wq"],
        "A_wo": _A_in["wo"],
        "B_x": _B_in["x"],
        "B_w1": _B_in["w1"],
        "B_w2": _B_in["w2"],
    }

def reference(A_x, A_k_cache, A_v_cache, A_wq, A_wo, B_x, B_w1, B_w2):
    def _A_ref(x, k_cache, v_cache, wq, wo):
        B, Sq, D = x.shape
        Hq, Dh = 32, 128
        Hkv, Sk = k_cache.shape[1], k_cache.shape[2]
        W = min(4096, max(256, Sk // 4))
        rep = Hq // Hkv
        q = (lambda x, *d: x.permute(*d))((x @ wq).reshape(B, Sq, Hq, Dh), 0, 2, 1, 3)
        k = (lambda x, n, axis: torch.repeat_interleave(x, n, dim=axis))(k_cache[:, :, Sk - W:, :], rep, axis=1)
        v = (lambda x, n, axis: torch.repeat_interleave(x, n, dim=axis))(v_cache[:, :, Sk - W:, :], rep, axis=1)
        scores = torch.einsum("bhqd,bhkd->bhqk", q, k) * (Dh ** -0.5)
        p = _softmax(scores, axis=-1)
        o = torch.einsum("bhqk,bhkd->bhqd", p, v)
        return (lambda x, *d: x.permute(*d))(o, 0, 2, 1, 3).reshape(B, Sq, Hq * Dh) @ wo

    def _B_ref(x, w1, w2):
        h = torch.einsum("bsd,df->bsf", x, w1)
        h = _silu(h)
        out = torch.einsum("bsf,fd->bsd", h, w2)
        return out

    x = A_x
    xn = _layernorm(x, axis=-1)
    return x + _A_ref(xn, A_k_cache, A_v_cache, A_wq, A_wo) + _B_ref(xn, B_w1, B_w2)
```

```asm
; @launch grid=(256,1,1) block=(1024,1,1) lds=140800
.amdgcn_target "amdgcn-amd-amdhsa--gfx950"
.text
.globl parallel_sum__sliding_block_cached__dense_activation_silu__decode_kernel
.p2align 8
.type parallel_sum__sliding_block_cached__dense_activation_silu__decode_kernel,@function
parallel_sum__sliding_block_cached__dense_activation_silu__decode_kernel:
    v_readfirstlane_b32 s5, v0
    s_lshr_b32 s4, s2, 3
    s_cmp_ge_u32 s4, 32
    s_cbranch_scc1 L_end
    v_mov_b32 v126, 138240
    v_and_b32 v0, 63, v0
    s_cmpk_gt_u32 s5, 256
    s_cbranch_scc1 L_z
    s_load_dwordx16 s[16:31], s[0:1], 0
    s_load_dwordx2 s[36:37], s[0:1], 80
    s_lshl2_add_u32 s8, s2, s4
    s_and_b32 s8, s8, 7
    s_lshr_b32 s11, s2, 6
    s_add_u32 s12, s2, 2
    s_and_b32 s12, s12, 7
    s_lshl2_add_u32 s11, s12, s11
    v_lshrrev_b32 v4, 4, v0
    v_and_b32 v5, 15, v0
    v_lshlrev_b32 v6, 2, v4
    v_xor_b32 v5, v5, v6
    v_lshlrev_b32 v5, 4, v5
    v_lshl_add_u32 v2, v4, 13, v5
    v_lshlrev_b32 v1, 4, v0
    s_lshl_b32 s42, s8, 12
    s_add_u32 s42, s42, s11
    s_lshl_b32 s42, s42, 8
    s_lshl_b32 s34, 1, 23
    s_lshl_b32 s35, 1, 17
    s_lshr_b32 s43, s34, 8
    s_mov_b32 m0, 0
    s_cmp_lg_u32 s5, 0
    s_barrier
    s_waitcnt lgkmcnt(0)
    s_cbranch_scc1 L_fx
    s_mov_b64 s[32:33], s[22:23]
LL0:
    buffer_load_dwordx4 v2, s[32:35], s42 offen nt lds
    s_addk_i32 m0, 1056
    s_add_u32 s42, s42, s43
    buffer_load_dwordx4 v2, s[32:35], s42 offen nt lds
    s_addk_i32 m0, 1056
    s_add_u32 s42, s42, s43
    s_cmpk_lt_u32 m0, 33792
    s_cbranch_scc1 LL0
    s_branch L_w0t
L_fx:
    global_load_dwordx4 v[8:11], v1, s[16:17]
    global_load_dwordx4 v[12:15], v1, s[16:17] offset:1024
    s_branch L_comp
L_z:
    v_mov_b32 v6, 0
    v_lshl_add_u32 v5, v0, 2, v126
    ds_write2st64_b32 v5, v6, v6 offset1:1
    s_waitcnt lgkmcnt(0)
    s_barrier
L_e256:
L_x:
    s_load_dwordx16 s[16:31], s[0:1], 0
    s_load_dwordx2 s[36:37], s[0:1], 80
    s_lshl2_add_u32 s8, s2, s4
    s_and_b32 s8, s8, 7
    s_lshr_b32 s11, s2, 6
    s_add_u32 s12, s2, 2
    s_and_b32 s12, s12, 7
    s_lshl2_add_u32 s11, s12, s11
    s_cmpk_lt_u32 s5, 576
    s_cbranch_scc1 L_comp
    s_cmpk_eq_u32 s5, 576
    s_cbranch_scc1 L_ld2
    s_mov_b64 exec, 0
    s_cmpk_eq_u32 s5, 640
    s_cbranch_scc1 L_pad0
    s_cmpk_eq_u32 s5, 704
    s_cbranch_scc1 L_pad2
    s_cmpk_eq_u32 s5, 768
    s_cbranch_scc1 L_pad4
    s_cmpk_eq_u32 s5, 832
    s_cbranch_scc1 L_pad6
    s_cmpk_eq_u32 s5, 896
    s_cbranch_scc1 L_pad8
    s_branch L_pad10
L_ld2:
    s_mov_b64 exec, -1
    s_setprio 3
    s_and_b32 s3, s2, 7
    s_and_b32 s6, s2, 1
    s_lshr_b32 s7, s3, 1
    s_lshr_b32 s49, s12, 1
    s_lshl_b32 s9, s6, 5
    s_add_u32 s9, s9, s4
    s_mul_i32 s10, s6, 28
    s_add_u32 s10, s10, s4
    s_lshr_b32 s12, s10, 3
    s_mul_i32 s13, s7, 7
    s_add_u32 s50, s12, s13
    s_mul_i32 s13, s49, 7
    s_add_u32 s12, s12, s13
    s_and_b32 s13, s4, 3
    s_lshr_b32 s14, s9, 2
    s_lshl4_add_u32 s14, s49, s14
    v_mov_b32 v125, 1
    v_lshrrev_b32 v4, 4, v0
    v_and_b32 v5, 15, v0
    v_lshlrev_b32 v6, 2, v4
    v_xor_b32 v5, v5, v6
    v_lshlrev_b32 v5, 4, v5
    v_mul_u32_u24 v9, 7168, v4
    v_add_u32 v9, v9, v5
    v_lshl_add_u32 v10, v4, 8, v5
    v_lshl_add_u32 v11, v4, 11, v5
    v_mov_b32 v12, 8
    s_mov_b32 s35, 0x20000
    s_waitcnt lgkmcnt(0)
    s_lshl_b32 s45, s7, 24
    s_lshl_b32 s43, s9, 14
    s_add_u32 s45, s45, s43
    s_add_u32 s45, s45, 15728640
    s_lshl_b32 s46, s13, 9
    s_mul_i32 s54, s8, 917504
    s_lshl_b32 s43, s12, 8
    s_add_u32 s54, s54, s43
    s_mul_i32 s55, s7, 14
    s_lshr_b32 s43, s10, 2
    s_add_u32 s55, s55, s43
    s_lshl_b32 s55, s55, 17
    s_add_u32 s55, s55, s46
    s_cmp_ge_u32 s4, 28
    s_cselect_b32 s55, 0x7000000, s55
    s_cselect_b32 s54, s55, s54
    s_lshl_b32 s47, s14, 17
    s_add_u32 s47, s47, s46
    s_mov_b32 s62, 200000
W1:
    ds_read_b32 v127, v126 offset:28
    s_waitcnt lgkmcnt(0)
    v_readfirstlane_b32 s63, v127
    s_sub_u32 s62, s62, 1
    s_cbranch_scc1 E2
    s_cmp_lt_i32 s63, 9
    s_cbranch_scc1 W1
E2:
    s_mov_b32 s42, s45
    s_mov_b32 s32, s18
    s_mov_b32 s33, s19
    s_mov_b32 s34, 0x4000000
    s_mov_b32 m0, 67584
    s_mov_b32 s44, 16
LL3:
    s_waitcnt vmcnt(24)
    ds_write_b32 v126, v12
    buffer_load_dwordx4 v10, s[32:35], s42 offen nt lds
    s_add_u32 m0, m0, 1056
    v_add_u32 v12, 1, v12
    s_add_u32 s42, s42, 1024
    s_sub_u32 s44, s44, 1
    s_cmp_lg_u32 s44, 0
    s_cbranch_scc1 LL3
    s_mov_b32 s42, s54
    s_mov_b32 s32, s28
    s_mov_b32 s33, s29
    s_mov_b32 s34, 0x700000
    s_mov_b32 m0, 33792
    s_mov_b32 s44, 32
LL4:
    s_waitcnt vmcnt(24)
    ds_write_b32 v126, v12
    buffer_load_dwordx4 v9, s[32:35], s42 offen nt lds
    s_add_u32 m0, m0, 1056
    v_add_u32 v12, 1, v12
    s_add_u32 s42, s42, 28672
    s_sub_u32 s44, s44, 1
    s_cmp_lg_u32 s44, 0
    s_cbranch_scc1 LL4
    s_mov_b32 s42, s45
    s_mov_b32 s32, s20
    s_mov_b32 s33, s21
    s_mov_b32 s34, 0x4000000
    s_mov_b32 m0, 84480
    s_mov_b32 s44, 16
LL5:
    s_waitcnt vmcnt(24)
    ds_write_b32 v126, v12
    buffer_load_dwordx4 v10, s[32:35], s42 offen nt lds
    s_add_u32 m0, m0, 1056
    v_add_u32 v12, 1, v12
    s_add_u32 s42, s42, 1024
    s_sub_u32 s44, s44, 1
    s_cmp_lg_u32 s44, 0
    s_cbranch_scc1 LL5
    s_mov_b32 s62, 200000
W6:
    ds_read_b32 v127, v126 offset:4
    s_waitcnt lgkmcnt(0)
    v_readfirstlane_b32 s63, v127
    s_sub_u32 s62, s62, 1
    s_cbranch_scc1 E7
    s_cmp_lt_i32 s63, 4
    s_cbranch_scc1 W6
E7:
    s_mov_b32 s42, s55
    s_mov_b32 s32, s30
    s_mov_b32 s33, s31
    s_mov_b32 s34, 0x700000
    s_mov_b32 m0, 0
    s_mov_b32 s44, 16
LL8:
    s_waitcnt vmcnt(24)
    ds_write_b32 v126, v12
    buffer_load_dwordx4 v11, s[32:35], s42 offen nt lds
    s_add_u32 m0, m0, 768
    v_add_u32 v12, 2, v12
    buffer_load_dwordx4 v11, s[32:35], s42 offen offset:256 nt lds
    s_add_u32 m0, m0, 1312
    s_add_u32 s42, s42, 8192
    s_sub_u32 s44, s44, 1
    s_cmp_lg_u32 s44, 0
    s_cbranch_scc1 LL8
    s_mov_b32 s42, s47
    v_add_u32 v12, -16, v12
    s_mov_b32 s32, s24
    s_mov_b32 s33, s25
    s_mov_b32 s34, 0x800000
    s_mov_b32 m0, 101376
    s_mov_b32 s44, 16
LL9:
    s_waitcnt vmcnt(40)
    ds_write_b32 v126, v12
    buffer_load_dwordx4 v11, s[32:35], s42 offen nt lds
    s_add_u32 m0, m0, 768
    v_add_u32 v12, 2, v12
    buffer_load_dwordx4 v11, s[32:35], s42 offen offset:256 nt lds
    s_add_u32 m0, m0, 1312
    s_add_u32 s42, s42, 8192
    s_sub_u32 s44, s44, 1
    s_cmp_lg_u32 s44, 0
    s_cbranch_scc1 LL9
    v_mov_b32 v12, 128
    s_waitcnt vmcnt(32)
    ds_write_b32 v126, v12
    v_mov_b32 v12, 160
    s_waitcnt vmcnt(0)
    ds_write_b32 v126, v12
    s_endpgm
L_w0t:
    v_mov_b32 v3, 9
    s_waitcnt vmcnt(24)
    ds_write_b32 v126, v3 offset:28
    v_mov_b32 v3, 33
    s_waitcnt vmcnt(0)
    ds_write_b32 v126, v3 offset:28
L_end:
    s_endpgm
L_comp:
    s_lshr_b32 s5, s5, 6
    s_add_u32 s5, s5, 3
    s_and_b32 s5, s5, 7
    s_mov_b32 s38, 0x10000000
    s_mov_b32 s39, 0x20000
    v_lshlrev_b32 v113, 4, v0
    s_waitcnt lgkmcnt(0)
    s_load_dword s51, s[36:37], 0
    s_load_dwordx2 s[40:41], s[0:1], 64
    s_lshl_b32 s42, s11, 3
    s_add_u32 s42, s42, s8
    s_lshl_b32 s42, s42, 9
    s_add_u32 s42, s42, 65536
    s_and_b32 s3, s2, 7
    s_and_b32 s6, s2, 1
    s_lshr_b32 s7, s3, 1
    s_lshr_b32 s49, s12, 1
    s_lshl_b32 s9, s6, 5
    s_add_u32 s9, s9, s4
    s_mul_i32 s10, s6, 28
    s_add_u32 s10, s10, s4
    s_lshr_b32 s12, s10, 3
    s_mul_i32 s13, s7, 7
    s_add_u32 s50, s12, s13
    s_mul_i32 s13, s49, 7
    s_add_u32 s12, s12, s13
    s_and_b32 s13, s4, 3
    s_lshr_b32 s14, s9, 2
    s_lshl4_add_u32 s14, s49, s14
    v_mov_b32 v125, 1
    s_setprio 2
    v_and_b32 v117, 48, v0
    s_mov_b32 s56, 0x07060501
    s_mov_b32 s57, 0x07060502
    s_mov_b32 s58, 0x07060503
    s_mov_b32 s60, 0x0c04000c
    s_mov_b32 s61, 0x0402010c
    s_mov_b32 s52, 0xffff0000
    s_mov_b32 s53, 0x3f803f80
    v_lshrrev_b32 v4, 4, v0
    v_bfe_u32 v5, v0, 2, 2
    v_and_b32 v6, 3, v0
    v_and_b32 v7, 15, v0
    v_mul_u32_u24 v120, 320, v5
    v_lshl_add_u32 v120, v6, 3, v120
    v_mul_u32_u24 v121, 1056, v4
    v_mul_u32_u24 v122, 2080, v4
    v_add_u32 v118, 135168, v117
    s_and_b32 s15, s5, 3
    s_lshl_b32 s15, s15, 6
    v_xor_b32 v112, s15, v120
    v_xor_b32 v111, 32, v112
    v_add_u32 v116, v112, v121
    v_add_u32 v115, v111, v121
    v_lshl_add_u32 v114, v7, 6, v117
    s_cmp_lt_u32 s5, 4
    s_cbranch_scc1 L_aw
    v_bfe_u32 v17, v0, 1, 2
    v_lshl_add_u32 v17, v4, 2, v17
    v_lshlrev_b32 v17, 4, v17
    v_and_b32 v18, 8, v0
    v_add_u32 v17, v17, v18
    v_and_b32 v18, 1, v0
    v_lshl_add_u32 v17, v18, 2, v17
    v_add_u32 v17, 135168, v17
    v_mov_b32 v20, 0
    v_add_u32 v2, v113, v126
    s_lshl_b32 s43, s8, 8
    v_lshl_add_u32 v3, v0, 2, v126
    v_add_u32 v3, s43, v3
    s_waitcnt vmcnt(0)
    ds_write_b128 v2, v[8:11] offset:512
    ds_write_b128 v2, v[12:15] offset:1536
    ds_read_b32 v16, v3 offset:512
L_pad0:
    s_cbranch_execz L_pad1
    v_dot2_f32_bf16 v20, v8, s53, v20
    v_dot2_f32_bf16 v20, v9, s53, v20
    v_dot2_f32_bf16 v20, v10, s53, v20
    v_dot2_f32_bf16 v20, v11, s53, v20
    v_dot2_f32_bf16 v20, v12, s53, v20
    v_dot2_f32_bf16 v20, v13, s53, v20
    v_dot2_f32_bf16 v20, v14, s53, v20
    v_dot2_f32_bf16 v20, v15, s53, v20
    v_lshlrev_b32 v24, 16, v8
    v_and_b32 v25, s52, v8
    v_lshlrev_b32 v26, 16, v9
    v_and_b32 v27, s52, v9
    v_lshlrev_b32 v28, 16, v10
    v_and_b32 v29, s52, v10
    v_lshlrev_b32 v30, 16, v11
    v_and_b32 v31, s52, v11
    v_lshlrev_b32 v32, 16, v12
    v_and_b32 v33, s52, v12
    v_lshlrev_b32 v34, 16, v13
    v_and_b32 v35, s52, v13
    v_lshlrev_b32 v36, 16, v14
    v_and_b32 v37, s52, v14
    v_lshlrev_b32 v38, 16, v15
    v_and_b32 v39, s52, v15
    s_nop 1
    v_add_f32_dpp v20, v20, v20 quad_perm:[1,0,3,2] row_mask:0xf bank_mask:0xf
    s_nop 1
    v_add_f32_dpp v20, v20, v20 quad_perm:[2,3,0,1] row_mask:0xf bank_mask:0xf
    s_nop 1
    v_add_f32_dpp v20, v20, v20 row_half_mirror row_mask:0xf bank_mask:0xf
    s_nop 1
    v_add_f32_dpp v20, v20, v20 row_mirror row_mask:0xf bank_mask:0xf
    v_mov_b32 v21, v20
    s_nop 1
    v_permlane16_swap_b32 v20, v21
    s_nop 1
    v_add_f32 v20, v20, v21
    v_mov_b32 v21, v20
    s_nop 1
    v_permlane32_swap_b32 v20, v21
    s_nop 1
    v_add_f32 v20, v20, v21
    v_mul_f32 v20, 0xba800000, v20
    v_mov_b32 v21, v20
    v_mov_b32 v22, 0
    v_mov_b32 v23, 0
    v_pk_add_f32 v[24:25], v[24:25], v[20:21]
    v_pk_add_f32 v[26:27], v[26:27], v[20:21]
    v_pk_add_f32 v[28:29], v[28:29], v[20:21]
    v_pk_add_f32 v[30:31], v[30:31], v[20:21]
    v_pk_add_f32 v[32:33], v[32:33], v[20:21]
    v_pk_add_f32 v[34:35], v[34:35], v[20:21]
    v_pk_add_f32 v[36:37], v[36:37], v[20:21]
    v_pk_add_f32 v[38:39], v[38:39], v[20:21]
    v_pk_fma_f32 v[22:23], v[24:25], v[24:25], v[22:23]
    v_pk_fma_f32 v[22:23], v[26:27], v[26:27], v[22:23]
    v_pk_fma_f32 v[22:23], v[28:29], v[28:29], v[22:23]
    v_pk_fma_f32 v[22:23], v[30:31], v[30:31], v[22:23]
    v_pk_fma_f32 v[22:23], v[32:33], v[32:33], v[22:23]
    v_pk_fma_f32 v[22:23], v[34:35], v[34:35], v[22:23]
    v_pk_fma_f32 v[22:23], v[36:37], v[36:37], v[22:23]
    v_pk_fma_f32 v[22:23], v[38:39], v[38:39], v[22:23]
    v_add_f32 v22, v22, v23
    s_nop 1
    v_add_f32_dpp v22, v22, v22 quad_perm:[1,0,3,2] row_mask:0xf bank_mask:0xf
    s_nop 1
    v_add_f32_dpp v22, v22, v22 quad_perm:[2,3,0,1] row_mask:0xf bank_mask:0xf
    s_nop 1
    v_add_f32_dpp v22, v22, v22 row_half_mirror row_mask:0xf bank_mask:0xf
    s_nop 1
    v_add_f32_dpp v22, v22, v22 row_mirror row_mask:0xf bank_mask:0xf
    v_mov_b32 v23, v22
    s_nop 1
    v_permlane16_swap_b32 v22, v23
    s_nop 1
    v_add_f32 v22, v22, v23
    v_mov_b32 v23, v22
    s_nop 1
    v_permlane32_swap_b32 v22, v23
    s_nop 1
    v_add_f32 v22, v22, v23
    v_mul_f32 v22, 0x3a800000, v22
    v_cvt_pk_bf16_f32 v20, v20, v22
    v_and_b32 v22, s52, v20
    v_lshlrev_b32 v20, 16, v20
    v_add_f32 v22, 0x3727c5ac, v22
    v_cvt_pk_bf16_f32 v22, v22, v22
    v_and_b32 v22, s52, v22
    v_sqrt_f32 v22, v22
    s_nop 0
    v_cvt_pk_bf16_f32 v22, v22, v22
    v_and_b32 v22, s52, v22
    v_rcp_f32 v23, v22
    s_waitcnt lgkmcnt(0)
    v_lshlrev_b32 v24, 16, v16
    v_and_b32 v25, s52, v16
    v_add_f32 v24, v24, v20
L_pad1:
    s_cbranch_execz L_end
    v_add_f32 v25, v25, v20
    v_cvt_pk_bf16_f32 v24, v24, v25
    v_and_b32 v25, s52, v24
    v_lshlrev_b32 v24, 16, v24
    v_mul_f32 v26, v24, v23
    v_mul_f32 v27, v25, v23
    v_fma_f32 v24, -v26, v22, v24
    v_fma_f32 v25, -v27, v22, v25
    v_fma_f32 v26, v24, v23, v26
    v_fma_f32 v27, v25, v23, v27
    v_cvt_pk_bf16_f32 v24, v26, v27
    ds_write_b32 v17, v24
    ds_read_b128 v[8:11], v118 offset:0
    ds_read_b128 v[12:15], v118 offset:64
    ds_read_b128 v[16:19], v118 offset:128
    ds_read_b128 v[20:23], v118 offset:192
    s_lshl_b32 s43, s15, 1
    s_add_u32 s42, s42, s43
    s_mov_b32 s44, 0x00030003
    s_mov_b32 s45, 0x00030003
    v_cmp_eq_u32 s[46:47], 1, v7
    s_mul_i32 s59, s51, 0x9e3779b1
    s_add_u32 s59, s59, 0x7f4a7c15
    s_add_u32 s51, s51, 1
    v_lshlrev_b32 v28, 2, v0
    v_and_b32 v29, 3, v0
    v_lshlrev_b32 v29, 1, v29
    v_bfe_u32 v29, s51, v29, 2
    s_mov_b32 s62, 200000
W10:
    ds_read_b32 v127, v126 offset:28
    s_waitcnt lgkmcnt(0)
    v_readfirstlane_b32 s63, v127
    s_sub_u32 s62, s62, 1
    s_cbranch_scc1 E11
    s_cmp_lt_i32 s63, 33
    s_cbranch_scc1 W10
E11:
    ds_read_b64_tr_b16 v[48:49], v116 offset:0
    ds_read_b64_tr_b16 v[50:51], v116 offset:4224
    ds_read_b64_tr_b16 v[52:53], v116 offset:8448
    ds_read_b64_tr_b16 v[54:55], v116 offset:12672
    ds_read_b64_tr_b16 v[56:57], v116 offset:16896
    ds_read_b64_tr_b16 v[58:59], v116 offset:21120
    ds_read_b64_tr_b16 v[60:61], v116 offset:25344
    ds_read_b64_tr_b16 v[62:63], v116 offset:29568
    s_waitcnt lgkmcnt(4)
    ds_read_b64_tr_b16 v[64:65], v115 offset:0
    ds_read_b64_tr_b16 v[66:67], v115 offset:4224
    ds_read_b64_tr_b16 v[68:69], v115 offset:8448
    ds_read_b64_tr_b16 v[70:71], v115 offset:12672
    ds_read_b64_tr_b16 v[72:73], v115 offset:16896
    ds_read_b64_tr_b16 v[74:75], v115 offset:21120
    ds_read_b64_tr_b16 v[76:77], v115 offset:25344
    ds_read_b64_tr_b16 v[78:79], v115 offset:29568
    v_mfma_f32_16x16x32_bf16 v[24:27], v[8:11], v[48:51], 0
    v_mfma_f32_16x16x32_bf16 v[24:27], v[12:15], v[52:55], v[24:27]
    s_waitcnt lgkmcnt(8)
    v_mfma_f32_16x16x32_bf16 v[24:27], v[16:19], v[56:59], v[24:27]
    v_mfma_f32_16x16x32_bf16 v[24:27], v[20:23], v[60:63], v[24:27]
    s_waitcnt lgkmcnt(6)
    v_mfma_f32_16x16x32_bf16 v[80:83], v[8:11], v[64:67], 0
    s_waitcnt lgkmcnt(4)
    v_mfma_f32_16x16x32_bf16 v[80:83], v[12:15], v[68:71], v[80:83]
    s_waitcnt lgkmcnt(2)
    v_mfma_f32_16x16x32_bf16 v[80:83], v[16:19], v[72:75], v[80:83]
    s_waitcnt lgkmcnt(0)
    v_mfma_f32_16x16x32_bf16 v[80:83], v[20:23], v[76:79], v[80:83]
    s_mov_b64 exec, 1
    ds_add_u32 v126, v125 offset:4
    s_mov_b64 exec, -1
    s_nop 4
    v_cndmask_b32 v24, v24, v80, s[52:53]
    v_add_u32 v24, 2, v24
    v_and_or_b32 v24, v24, -4, v29
    s_mov_b32 exec_hi, 0
    buffer_store_dword v24, v28, s[36:39], s42 offen sc1
    s_mov_b32 exec_hi, -1
    s_cmp_lg_u32 s5, 7
    s_cbranch_scc1 L_nf
    s_lshl_b32 s48, s11, 3
    s_add_u32 s48, s48, s8
    s_lshl_b32 s48, s48, 11
    s_add_u32 s48, s48, 1671168
    v_mov_b32 v40, s59
    v_lshlrev_b32 v41, 7, v0
    s_mov_b64 exec, 0xffff
    buffer_store_dword v40, v41, s[36:39], s48 offen sc1
    s_mov_b64 exec, -1
L_pad2:
    s_cbranch_execz L_pad3
    s_nop 0
L_nf:
    v_mov_b32 v40, 0
    v_mov_b32 v41, 0
    v_mov_b32 v42, 0
    v_mov_b32 v43, 0
    v_mov_b32 v44, 0
    v_mov_b32 v45, 0
    v_mov_b32 v46, 0
    v_mov_b32 v47, 0
    s_cmp_ge_u32 s4, 28
    s_cbranch_scc1 L_wo
    s_lshl_b32 s42, s12, 12
    s_lshl_b32 s43, s15, 4
    s_add_u32 s42, s42, s43
    s_lshl_b32 s43, s8, 7
    s_add_u32 s42, s42, s43
    s_add_u32 s42, s42, 196608
    s_mov_b32 s62, 200000
W12:
    ds_read_b32 v127, v126 offset:0
    s_waitcnt lgkmcnt(0)
    v_readfirstlane_b32 s63, v127
    s_sub_u32 s62, s62, 1
    s_cbranch_scc1 E13
    s_cmp_lt_i32 s63, 80
    s_cbranch_scc1 W12
E13:
    ds_read_b64_tr_b16 v[48:49], v116 offset:33792
    ds_read_b64_tr_b16 v[50:51], v116 offset:38016
    ds_read_b64_tr_b16 v[52:53], v116 offset:42240
    ds_read_b64_tr_b16 v[54:55], v116 offset:46464
    ds_read_b64_tr_b16 v[56:57], v116 offset:50688
    ds_read_b64_tr_b16 v[58:59], v116 offset:54912
    ds_read_b64_tr_b16 v[60:61], v116 offset:59136
    ds_read_b64_tr_b16 v[62:63], v116 offset:63360
    s_waitcnt lgkmcnt(4)
    ds_read_b64_tr_b16 v[64:65], v115 offset:33792
    ds_read_b64_tr_b16 v[66:67], v115 offset:38016
    ds_read_b64_tr_b16 v[68:69], v115 offset:42240
    ds_read_b64_tr_b16 v[70:71], v115 offset:46464
    ds_read_b64_tr_b16 v[72:73], v115 offset:50688
    ds_read_b64_tr_b16 v[74:75], v115 offset:54912
    ds_read_b64_tr_b16 v[76:77], v115 offset:59136
    ds_read_b64_tr_b16 v[78:79], v115 offset:63360
    v_mfma_f32_16x16x32_bf16 v[24:27], v[48:51], v[8:11], 0
    v_mfma_f32_16x16x32_bf16 v[24:27], v[52:55], v[12:15], v[24:27]
    s_waitcnt lgkmcnt(8)
    v_mfma_f32_16x16x32_bf16 v[24:27], v[56:59], v[16:19], v[24:27]
    v_mfma_f32_16x16x32_bf16 v[24:27], v[60:63], v[20:23], v[24:27]
    s_waitcnt lgkmcnt(6)
    v_mfma_f32_16x16x32_bf16 v[80:83], v[64:67], v[8:11], 0
    s_waitcnt lgkmcnt(4)
    v_mfma_f32_16x16x32_bf16 v[80:83], v[68:71], v[12:15], v[80:83]
    s_waitcnt lgkmcnt(2)
    v_mfma_f32_16x16x32_bf16 v[80:83], v[72:75], v[16:19], v[80:83]
    s_waitcnt lgkmcnt(0)
    v_mfma_f32_16x16x32_bf16 v[80:83], v[76:79], v[20:23], v[80:83]
    s_nop 7
    v_cndmask_b32 v24, v24, v80, s[46:47]
    v_cndmask_b32 v25, v25, v81, s[46:47]
    v_cndmask_b32 v26, v26, v82, s[46:47]
    v_cndmask_b32 v27, v27, v83, s[46:47]
    v_perm_b32 v28, v24, v27, s56
    v_perm_b32 v29, v25, v27, s57
    v_perm_b32 v30, v26, v27, s58
    v_mov_b32 v31, s59
    s_mov_b64 exec, s[44:45]
    buffer_store_dwordx4 v[28:31], v114, s[36:39], s42 offen sc1
    s_mov_b64 exec, -1
    s_cmp_ge_u32 s5, 6
    s_cbranch_scc1 L_w2
    s_and_b32 s43, s10, 4
    s_lshl_b32 s43, s43, 9
    s_lshl_b32 s42, s50, 12
    s_add_u32 s42, s42, s43
    s_lshl_b32 s43, s15, 4
    s_add_u32 s42, s42, s43
    s_add_u32 s42, s42, 196608
    v_and_b32 v49, 4, v0
    v_lshlrev_b32 v49, 1, v49
    v_lshl_add_u32 v49, v6, 4, v49
    v_lshl_add_u32 v49, v4, 1, v49
    s_add_u32 s43, s15, 137600
    v_add_u32 v49, s43, v49
    s_mov_b32 s62, 200000
W14:
    ds_read_b32 v127, v126 offset:0
    s_waitcnt lgkmcnt(0)
    v_readfirstlane_b32 s63, v127
    s_sub_u32 s62, s62, 1
    s_cbranch_scc1 E15
    s_cmp_lt_i32 s63, 104
    s_cbranch_scc1 W14
E15:
    buffer_load_dwordx4 v[24:27], v113, s[36:39], s42 offen sc1
L_pad3:
    s_cbranch_execz L_end
    s_mov_b32 s62, 200000
G16:
    s_waitcnt vmcnt(0)
    v_cmp_ne_u32 s[18:19], s59, v27
    s_cmp_lg_u64 s[18:19], 0
    s_cbranch_scc0 E17
    s_mov_b64 exec, s[18:19]
    buffer_load_dwordx4 v[24:27], v113, s[36:39], s42 offen sc1
    s_mov_b64 exec, -1
    s_sub_u32 s62, s62, 1
    s_cbranch_scc0 G16
    s_waitcnt vmcnt(0)
E17:
    v_perm_b32 v27, v25, v24, s60
    v_perm_b32 v27, v26, v27, s61
    v_permlane32_swap_b32 v24, v26
    s_nop 0
    v_permlane32_swap_b32 v25, v27
    v_pk_add_f32 v[24:25], v[24:25], v[26:27]
    s_nop 1
    v_permlane16_swap_b32 v24, v25
    v_add_f32 v24, v24, v25
    s_nop 1
    v_add_f32_dpp v24, v24, v24 row_ror:8 row_mask:0xf bank_mask:0xf
    v_cvt_pk_bf16_f32 v24, v24, v24
    v_and_b32 v24, s52, v24
    v_mul_f32 v25, 0xbfb8aa3b, v24
    v_exp_f32 v25, v25
    s_nop 0
    v_add_f32 v25, 1.0, v25
    v_rcp_f32 v25, v25
    s_nop 0
    v_mul_f32 v24, v24, v25
    v_cvt_pk_bf16_f32 v24, v24, v24
    ds_write_b16 v49, v24
    s_mov_b64 exec, 1
    ds_add_u32 v126, v125 offset:12
    s_mov_b64 exec, -1
L_w2:
    v_add_u32 v116, v112, v122
    v_add_u32 v115, v111, v122
    s_mov_b32 s62, 200000
W18:
    ds_read_b32 v127, v126 offset:12
    s_waitcnt lgkmcnt(0)
    v_readfirstlane_b32 s63, v127
    s_sub_u32 s62, s62, 1
    s_cbranch_scc1 E19
    s_cmp_lt_i32 s63, 2
    s_cbranch_scc1 W18
E19:
    ds_read_b128 v[8:11], v118 offset:2432
    ds_read_b128 v[12:15], v118 offset:2496
    s_mov_b32 s62, 200000
W20:
    ds_read_b32 v127, v126 offset:0
    s_waitcnt lgkmcnt(0)
    v_readfirstlane_b32 s63, v127
    s_sub_u32 s62, s62, 1
    s_cbranch_scc1 E21
    s_cmp_lt_i32 s63, 128
    s_cbranch_scc1 W20
E21:
    ds_read_b64_tr_b16 v[56:57], v116 offset:0
    ds_read_b64_tr_b16 v[58:59], v116 offset:8320
    ds_read_b64_tr_b16 v[60:61], v116 offset:16640
    ds_read_b64_tr_b16 v[62:63], v116 offset:24960
    ds_read_b64_tr_b16 v[64:65], v115 offset:0
    ds_read_b64_tr_b16 v[66:67], v115 offset:8320
    ds_read_b64_tr_b16 v[68:69], v115 offset:16640
    ds_read_b64_tr_b16 v[70:71], v115 offset:24960
    s_waitcnt lgkmcnt(0)
    ds_read_b64_tr_b16 v[72:73], v116 offset:1024
    ds_read_b64_tr_b16 v[74:75], v116 offset:9344
    ds_read_b64_tr_b16 v[76:77], v116 offset:17664
    ds_read_b64_tr_b16 v[78:79], v116 offset:25984
    ds_read_b64_tr_b16 v[80:81], v115 offset:1024
    ds_read_b64_tr_b16 v[82:83], v115 offset:9344
    ds_read_b64_tr_b16 v[84:85], v115 offset:17664
    ds_read_b64_tr_b16 v[86:87], v115 offset:25984
    v_mfma_f32_16x16x32_bf16 v[48:51], v[56:59], v[8:11], 0
    v_mfma_f32_16x16x32_bf16 v[48:51], v[60:63], v[12:15], v[48:51]
    v_mfma_f32_16x16x32_bf16 v[52:55], v[64:67], v[8:11], 0
    v_mfma_f32_16x16x32_bf16 v[52:55], v[68:71], v[12:15], v[52:55]
    s_waitcnt lgkmcnt(0)
    v_mfma_f32_16x16x32_bf16 v[40:43], v[72:75], v[8:11], 0
    v_mfma_f32_16x16x32_bf16 v[40:43], v[76:79], v[12:15], v[40:43]
    v_mfma_f32_16x16x32_bf16 v[44:47], v[80:83], v[8:11], 0
    v_mfma_f32_16x16x32_bf16 v[44:47], v[84:87], v[12:15], v[44:47]
    v_cmp_eq_u32 vcc, 1, v7
    v_and_b32 v24, 1, v0
    v_lshl_add_u32 v24, v24, 6, v117
    s_lshl_b32 s15, s15, 1
    s_add_u32 s15, s15, 137728
    v_add_u32 v24, s15, v24
    v_cndmask_b32 v48, v48, v52, vcc
    v_cndmask_b32 v49, v49, v53, vcc
L_pad4:
    s_cbranch_execz L_pad5
    v_cndmask_b32 v50, v50, v54, vcc
    v_cndmask_b32 v51, v51, v55, vcc
    s_mov_b32 s44, 0x00030003
    s_mov_b64 exec, s[44:45]
    ds_write_b128 v24, v[48:51]
    s_mov_b64 exec, -1
    s_mov_b64 exec, 1
    ds_add_u32 v126, v125 offset:20
    s_mov_b64 exec, -1
    s_branch L_wo
L_aw:
    v_lshlrev_b32 v24, 2, v0
    s_movk_i32 s46, 0x800
    buffer_load_dword v24, v24, s[36:39], s46 offen
    s_lshl_b32 s46, s7, 2
    s_add_u32 s46, s46, s5
    s_lshl_b32 s42, s46, 13
    s_add_u32 s42, s42, 65536
    s_add_u32 s43, s42, 4096
    v_and_b32 v48, 31, v0
    v_lshlrev_b32 v48, 3, v48
    v_lshrrev_b32 v49, 5, v0
    v_lshl_add_u32 v48, v49, 2, v48
    s_mul_i32 s15, s5, 544
    s_add_u32 s15, s15, 135424
    v_add_u32 v48, s15, v48
    v_mul_u32_u24 v50, 1056, v5
    v_mul_u32_u24 v51, 320, v6
    v_add_u32 v51, v51, v117
    v_add_u32 v50, 67584, v50
    v_xor_b32 v52, 0, v51
    v_add_u32 v52, v52, v50
    v_xor_b32 v53, 64, v51
    v_add_u32 v53, v53, v50
    v_xor_b32 v54, 128, v51
    v_add_u32 v54, v54, v50
    v_xor_b32 v55, 192, v51
    v_add_u32 v55, v55, v50
    v_and_b32 v50, 7, v0
    v_mul_u32_u24 v50, 272, v50
    v_add_u32 v50, v50, v117
    v_add_u32 v50, 135424, v50
    v_add_u32 v116, 84480, v116
    v_add_u32 v115, 84480, v115
    s_waitcnt lgkmcnt(0)
    s_mul_i32 s59, s51, 0x9e3779b1
    s_add_u32 s59, s59, 0x7f4a7c15
    s_add_u32 s51, s51, 1
    s_and_b32 s48, s51, 255
    s_mul_i32 s48, s48, 0x01010101
    s_lshl_b32 s44, s46, 4
    s_and_b32 s45, s9, 3
    s_add_u32 s44, s44, s45
    s_lshl_b32 s44, s44, 4
    s_bfe_u32 s45, s9, 0x40002
    s_add_u32 s44, s44, s45
    s_lshl_b32 s44, s44, 7
    s_add_u32 s44, s44, 1671168
    s_add_u32 s44, s44, s36
    s_addc_u32 s45, s37, 0
    s_mov_b32 s54, s59
    s_mov_b32 s55, s59
    s_mov_b32 s62, 200000
W22:
    ds_read_b32 v127, v126 offset:0
    s_waitcnt lgkmcnt(0)
    v_readfirstlane_b32 s63, v127
    s_sub_u32 s62, s62, 1
    s_cbranch_scc1 E23
    s_cmp_lt_i32 s63, 33
    s_cbranch_scc1 W22
E23:
    s_mov_b32 s62, 60
L_sf:
    s_load_dword s18, s[44:45], 0 glc
    s_load_dword s19, s[44:45], 8192 glc
    s_load_dword s20, s[44:45], 16384 glc
    s_load_dword s21, s[44:45], 24576 glc
    s_waitcnt lgkmcnt(0)
    s_xor_b64 s[18:19], s[18:19], s[54:55]
    s_xor_b64 s[20:21], s[20:21], s[54:55]
    s_or_b64 s[18:19], s[18:19], s[20:21]
    s_cbranch_scc0 L_sf2
    s_sub_u32 s62, s62, 1
    s_cbranch_scc0 L_sf
L_sf2:
    buffer_load_dwordx4 v[24:27], v113, s[36:39], s42 offen offset:0
    buffer_load_dwordx4 v[28:31], v113, s[36:39], s42 offen offset:1024
    buffer_load_dwordx4 v[32:35], v113, s[36:39], s42 offen offset:2048
    buffer_load_dwordx4 v[36:39], v113, s[36:39], s42 offen offset:3072
    buffer_load_dwordx4 v[40:43], v113, s[36:39], s43 offen offset:0
    buffer_load_dwordx4 v[44:47], v113, s[36:39], s43 offen offset:1024
    buffer_load_dwordx4 v[104:107], v113, s[36:39], s43 offen offset:2048
    buffer_load_dwordx4 v[120:123], v113, s[36:39], s43 offen offset:3072
    s_mov_b32 s62, 200000
W24:
    ds_read_b32 v127, v126 offset:0
    s_waitcnt lgkmcnt(0)
    v_readfirstlane_b32 s63, v127
    s_sub_u32 s62, s62, 1
    s_cbranch_scc1 E25
    s_cmp_lt_i32 s63, 48
    s_cbranch_scc1 W24
E25:
L_pad5:
    s_cbranch_execz L_end
    ds_read_b128 v[56:59], v52 offset:0
    ds_read_b128 v[60:63], v53 offset:0
    ds_read_b128 v[64:67], v54 offset:0
    ds_read_b128 v[68:71], v55 offset:0
    ds_read_b128 v[72:75], v52 offset:4224
    ds_read_b128 v[76:79], v53 offset:4224
    ds_read_b128 v[80:83], v54 offset:4224
    ds_read_b128 v[84:87], v55 offset:4224
    ds_read_b128 v[88:91], v52 offset:8448
    ds_read_b128 v[92:95], v53 offset:8448
    ds_read_b128 v[96:99], v54 offset:8448
    ds_read_b128 v[100:103], v55 offset:8448
    s_waitcnt lgkmcnt(4)
    ds_read_b128 v[8:11], v52 offset:12672
    ds_read_b128 v[12:15], v53 offset:12672
    ds_read_b128 v[16:19], v54 offset:12672
    ds_read_b128 v[20:23], v55 offset:12672
    s_mov_b32 s62, 200000
L_qg:
    s_waitcnt vmcnt(7)
    v_alignbit_b32 v108, v24, v108, 2
    v_and_b32 v24, -4, v24
    v_alignbit_b32 v108, v25, v108, 2
    v_and_b32 v25, -4, v25
    v_alignbit_b32 v108, v26, v108, 2
    v_and_b32 v26, -4, v26
    v_alignbit_b32 v108, v27, v108, 2
    v_and_b32 v27, -4, v27
    s_waitcnt vmcnt(6)
    v_alignbit_b32 v108, v28, v108, 2
    v_and_b32 v28, -4, v28
    v_alignbit_b32 v108, v29, v108, 2
    v_and_b32 v29, -4, v29
    v_alignbit_b32 v108, v30, v108, 2
    v_and_b32 v30, -4, v30
    v_alignbit_b32 v108, v31, v108, 2
    v_and_b32 v31, -4, v31
    s_waitcnt vmcnt(5)
    v_alignbit_b32 v108, v32, v108, 2
    v_and_b32 v32, -4, v32
    v_alignbit_b32 v108, v33, v108, 2
    v_and_b32 v33, -4, v33
    v_alignbit_b32 v108, v34, v108, 2
    v_and_b32 v34, -4, v34
    v_alignbit_b32 v108, v35, v108, 2
    v_and_b32 v35, -4, v35
    s_waitcnt vmcnt(4)
    v_alignbit_b32 v108, v36, v108, 2
    v_and_b32 v36, -4, v36
    v_alignbit_b32 v108, v37, v108, 2
    v_and_b32 v37, -4, v37
    v_alignbit_b32 v108, v38, v108, 2
    v_and_b32 v38, -4, v38
    v_alignbit_b32 v108, v39, v108, 2
    v_and_b32 v39, -4, v39
    s_waitcnt vmcnt(3)
    v_alignbit_b32 v109, v40, v109, 2
    v_and_b32 v40, -4, v40
    v_alignbit_b32 v109, v41, v109, 2
    v_and_b32 v41, -4, v41
    v_alignbit_b32 v109, v42, v109, 2
    v_and_b32 v42, -4, v42
    v_alignbit_b32 v109, v43, v109, 2
    v_and_b32 v43, -4, v43
    s_waitcnt vmcnt(2)
    v_alignbit_b32 v109, v44, v109, 2
    v_and_b32 v44, -4, v44
    v_alignbit_b32 v109, v45, v109, 2
    v_and_b32 v45, -4, v45
    v_alignbit_b32 v109, v46, v109, 2
    v_and_b32 v46, -4, v46
    v_alignbit_b32 v109, v47, v109, 2
    v_and_b32 v47, -4, v47
    s_waitcnt vmcnt(1)
    v_alignbit_b32 v109, v104, v109, 2
    v_and_b32 v104, -4, v104
    v_alignbit_b32 v109, v105, v109, 2
    v_and_b32 v105, -4, v105
    v_alignbit_b32 v109, v106, v109, 2
    v_and_b32 v106, -4, v106
    v_alignbit_b32 v109, v107, v109, 2
    v_and_b32 v107, -4, v107
    s_waitcnt vmcnt(0)
    v_alignbit_b32 v109, v120, v109, 2
    v_and_b32 v120, -4, v120
    v_alignbit_b32 v109, v121, v109, 2
    v_and_b32 v121, -4, v121
    v_alignbit_b32 v109, v122, v109, 2
L_pad6:
    s_cbranch_execz L_pad7
    v_and_b32 v122, -4, v122
    v_alignbit_b32 v109, v123, v109, 2
    v_and_b32 v123, -4, v123
    v_cmp_ne_u32 s[18:19], s48, v108
    v_cmp_ne_u32 vcc, s48, v109
    s_or_b64 s[18:19], s[18:19], vcc
    s_cbranch_scc0 L_qe
    buffer_load_dwordx4 v[24:27], v113, s[36:39], s42 offen offset:0 sc1
    buffer_load_dwordx4 v[28:31], v113, s[36:39], s42 offen offset:1024 sc1
    buffer_load_dwordx4 v[32:35], v113, s[36:39], s42 offen offset:2048 sc1
    buffer_load_dwordx4 v[36:39], v113, s[36:39], s42 offen offset:3072 sc1
    buffer_load_dwordx4 v[40:43], v113, s[36:39], s43 offen offset:0 sc1
    buffer_load_dwordx4 v[44:47], v113, s[36:39], s43 offen offset:1024 sc1
    buffer_load_dwordx4 v[104:107], v113, s[36:39], s43 offen offset:2048 sc1
    buffer_load_dwordx4 v[120:123], v113, s[36:39], s43 offen offset:3072 sc1
    s_sub_u32 s62, s62, 1
    s_cbranch_scc0 L_qg
    s_waitcnt vmcnt(0)
L_qe:
    v_pk_add_f32 v[24:25], v[24:25], v[28:29]
    v_pk_add_f32 v[26:27], v[26:27], v[30:31]
    v_pk_add_f32 v[32:33], v[32:33], v[36:37]
    v_pk_add_f32 v[34:35], v[34:35], v[38:39]
    v_pk_add_f32 v[40:41], v[40:41], v[44:45]
    v_pk_add_f32 v[42:43], v[42:43], v[46:47]
    v_pk_add_f32 v[104:105], v[104:105], v[120:121]
    v_pk_add_f32 v[106:107], v[106:107], v[122:123]
    v_pk_add_f32 v[24:25], v[24:25], v[32:33]
    v_pk_add_f32 v[26:27], v[26:27], v[34:35]
    v_pk_add_f32 v[40:41], v[40:41], v[104:105]
    v_pk_add_f32 v[42:43], v[42:43], v[106:107]
    s_nop 0
    v_permlane32_swap_b32 v24, v26
    v_permlane32_swap_b32 v25, v27
    v_permlane32_swap_b32 v40, v42
    v_permlane32_swap_b32 v41, v43
    v_pk_add_f32 v[24:25], v[24:25], v[26:27]
    v_pk_add_f32 v[40:41], v[40:41], v[42:43]
    v_cvt_pk_bf16_f32 v24, v24, v25
    v_cvt_pk_bf16_f32 v40, v40, v41
    ds_write_b32 v48, v24
    ds_write_b32 v48, v40 offset:272
    s_mov_b64 exec, 1
    ds_add_u32 v126, v125 offset:8
    s_mov_b64 exec, -1
    v_mul_u32_u24 v122, 2080, v4
    s_mov_b32 s62, 200000
W26:
    ds_read_b32 v127, v126 offset:8
    s_waitcnt lgkmcnt(0)
    v_readfirstlane_b32 s63, v127
    s_sub_u32 s62, s62, 1
    s_cbranch_scc1 E27
    s_cmp_lt_i32 s63, 4
    s_cbranch_scc1 W26
E27:
    ds_read_b128 v[24:27], v50 offset:0
    ds_read_b128 v[28:31], v50 offset:64
    ds_read_b128 v[32:35], v50 offset:128
    ds_read_b128 v[36:39], v50 offset:192
    s_waitcnt lgkmcnt(3)
    v_mfma_f32_16x16x32_bf16 v[40:43], v[56:59], v[24:27], 0
    v_mfma_f32_16x16x32_bf16 v[44:47], v[72:75], v[24:27], 0
    v_mfma_f32_16x16x32_bf16 v[104:107], v[88:91], v[24:27], 0
    v_mfma_f32_16x16x32_bf16 v[108:111], v[8:11], v[24:27], 0
    s_waitcnt lgkmcnt(2)
    v_mfma_f32_16x16x32_bf16 v[40:43], v[60:63], v[28:31], v[40:43]
    v_mfma_f32_16x16x32_bf16 v[44:47], v[76:79], v[28:31], v[44:47]
    v_mfma_f32_16x16x32_bf16 v[104:107], v[92:95], v[28:31], v[104:107]
    v_mfma_f32_16x16x32_bf16 v[108:111], v[12:15], v[28:31], v[108:111]
    s_waitcnt lgkmcnt(1)
    v_mfma_f32_16x16x32_bf16 v[40:43], v[64:67], v[32:35], v[40:43]
    v_mfma_f32_16x16x32_bf16 v[44:47], v[80:83], v[32:35], v[44:47]
    v_mfma_f32_16x16x32_bf16 v[104:107], v[96:99], v[32:35], v[104:107]
    v_mfma_f32_16x16x32_bf16 v[108:111], v[16:19], v[32:35], v[108:111]
    s_waitcnt lgkmcnt(0)
    v_mfma_f32_16x16x32_bf16 v[40:43], v[68:71], v[36:39], v[40:43]
    v_mfma_f32_16x16x32_bf16 v[44:47], v[84:87], v[36:39], v[44:47]
    v_mfma_f32_16x16x32_bf16 v[104:107], v[100:103], v[36:39], v[104:107]
    v_mfma_f32_16x16x32_bf16 v[108:111], v[20:23], v[36:39], v[108:111]
    s_mov_b32 s62, 200000
W28:
    ds_read_b32 v127, v126 offset:0
    s_waitcnt lgkmcnt(0)
    v_readfirstlane_b32 s63, v127
    s_sub_u32 s62, s62, 1
    s_cbranch_scc1 E29
L_pad7:
    s_cbranch_execz L_end
    s_cmp_lt_i32 s63, 96
    s_cbranch_scc1 W28
E29:
    ds_read_b64_tr_b16 v[56:57], v116 offset:0
    ds_read_b64_tr_b16 v[58:59], v116 offset:4224
    ds_read_b64_tr_b16 v[60:61], v116 offset:8448
    ds_read_b64_tr_b16 v[62:63], v116 offset:12672
    ds_read_b64_tr_b16 v[64:65], v115 offset:0
    ds_read_b64_tr_b16 v[66:67], v115 offset:4224
    ds_read_b64_tr_b16 v[68:69], v115 offset:8448
    ds_read_b64_tr_b16 v[70:71], v115 offset:12672
    v_mov_b32_dpp v40, v104 quad_perm:[0,1,2,3] row_mask:0xf bank_mask:0xc
    v_mov_b32_dpp v41, v105 quad_perm:[0,1,2,3] row_mask:0xf bank_mask:0xc
    v_mov_b32_dpp v42, v106 quad_perm:[0,1,2,3] row_mask:0xf bank_mask:0xc
    v_mov_b32_dpp v43, v107 quad_perm:[0,1,2,3] row_mask:0xf bank_mask:0xc
    v_mov_b32_dpp v44, v108 quad_perm:[0,1,2,3] row_mask:0xf bank_mask:0xc
    v_mov_b32_dpp v45, v109 quad_perm:[0,1,2,3] row_mask:0xf bank_mask:0xc
    v_mov_b32_dpp v46, v110 quad_perm:[0,1,2,3] row_mask:0xf bank_mask:0xc
    v_mov_b32_dpp v47, v111 quad_perm:[0,1,2,3] row_mask:0xf bank_mask:0xc
    s_mov_b32 s44, 0x3db504f3
    s_mov_b32 s45, 0x3fb8aa3b
    v_cvt_pk_bf16_f32 v24, v40, v41
    v_cvt_pk_bf16_f32 v25, v42, v43
    v_cvt_pk_bf16_f32 v26, v44, v45
    v_cvt_pk_bf16_f32 v27, v46, v47
    v_lshlrev_b32 v40, 16, v24
    v_and_b32 v41, s52, v24
    v_lshlrev_b32 v42, 16, v25
    v_and_b32 v43, s52, v25
    v_lshlrev_b32 v44, 16, v26
    v_and_b32 v45, s52, v26
    v_lshlrev_b32 v46, 16, v27
    v_and_b32 v47, s52, v27
    v_mul_f32 v40, s44, v40
    v_mul_f32 v41, s44, v41
    v_mul_f32 v42, s44, v42
    v_mul_f32 v43, s44, v43
    v_mul_f32 v44, s44, v44
    v_mul_f32 v45, s44, v45
    v_mul_f32 v46, s44, v46
    v_mul_f32 v47, s44, v47
    v_cvt_pk_bf16_f32 v24, v40, v41
    v_cvt_pk_bf16_f32 v25, v42, v43
    v_cvt_pk_bf16_f32 v26, v44, v45
    v_cvt_pk_bf16_f32 v27, v46, v47
    v_lshlrev_b32 v40, 16, v24
    v_and_b32 v41, s52, v24
    v_lshlrev_b32 v42, 16, v25
    v_and_b32 v43, s52, v25
    v_lshlrev_b32 v44, 16, v26
    v_and_b32 v45, s52, v26
    v_lshlrev_b32 v46, 16, v27
    v_and_b32 v47, s52, v27
    v_max3_f32 v28, v40, v41, v42
    v_max3_f32 v29, v43, v44, v45
    v_max3_f32 v28, v28, v46, v47
    v_max_f32 v28, v28, v29
    s_nop 1
    v_max_f32_dpp v28, v28, v28 row_ror:8 row_mask:0xf bank_mask:0xf
    v_mov_b32 v29, v28
    s_nop 1
    v_permlane16_swap_b32 v28, v29
    s_nop 1
    v_max_f32 v28, v28, v29
    v_mov_b32 v29, v28
    s_nop 1
    v_permlane32_swap_b32 v28, v29
    s_nop 1
    v_max_f32 v28, v28, v29
    v_mul_f32 v28, s45, v28
    v_fma_f32 v40, v40, s45, -v28
    v_fma_f32 v41, v41, s45, -v28
    v_fma_f32 v42, v42, s45, -v28
    v_fma_f32 v43, v43, s45, -v28
    v_fma_f32 v44, v44, s45, -v28
    v_fma_f32 v45, v45, s45, -v28
    v_fma_f32 v46, v46, s45, -v28
    v_fma_f32 v47, v47, s45, -v28
    v_exp_f32 v40, v40
    v_exp_f32 v41, v41
    v_exp_f32 v42, v42
    v_exp_f32 v43, v43
    v_exp_f32 v44, v44
    v_exp_f32 v45, v45
    v_exp_f32 v46, v46
    v_exp_f32 v47, v47
    s_nop 0
    v_cvt_pk_bf16_f32 v24, v40, v41
    v_cvt_pk_bf16_f32 v25, v42, v43
    v_cvt_pk_bf16_f32 v26, v44, v45
    v_cvt_pk_bf16_f32 v27, v46, v47
    s_waitcnt lgkmcnt(0)
L_pad8:
    s_cbranch_execz L_pad9
    s_nop 0
    v_mfma_f32_16x16x32_bf16 v[72:75], v[56:59], v[24:27], 0
    v_mfma_f32_16x16x32_bf16 v[76:79], v[60:63], v[24:27], 0
    v_mfma_f32_16x16x32_bf16 v[80:83], v[64:67], v[24:27], 0
    v_mfma_f32_16x16x32_bf16 v[84:87], v[68:71], v[24:27], 0
    v_pk_add_f32 v[40:41], v[40:41], v[42:43]
    v_pk_add_f32 v[44:45], v[44:45], v[46:47]
    v_pk_add_f32 v[40:41], v[40:41], v[44:45]
    v_add_f32 v29, v40, v41
    s_nop 1
    v_add_f32_dpp v29, v29, v29 row_ror:8 row_mask:0xf bank_mask:0xf
    v_mov_b32 v30, v29
    s_nop 1
    v_permlane16_swap_b32 v29, v30
    s_nop 1
    v_add_f32 v29, v29, v30
    v_mov_b32 v30, v29
    s_nop 1
    v_permlane32_swap_b32 v29, v30
    s_nop 1
    v_add_f32 v29, v29, v30
    v_mov_b32 v31, s59
    v_and_b32 v32, 7, v0
    v_lshlrev_b32 v33, 15, v32
    v_and_b32 v34, 8, v0
    v_lshl_add_u32 v33, v34, 3, v33
    v_add_u32 v33, v33, v117
    s_lshl_b32 s42, s7, 18
    s_lshr_b32 s43, s5, 1
    s_lshl_b32 s43, s43, 14
    s_add_u32 s42, s42, s43
    s_and_b32 s43, s5, 1
    s_lshl_b32 s43, s43, 7
    s_add_u32 s42, s42, s43
    s_lshl_b32 s43, s9, 8
    s_add_u32 s42, s42, s43
    s_add_u32 s42, s42, 360448
    s_lshl_b32 s46, s7, 13
    s_lshl_b32 s43, s9, 7
    s_add_u32 s46, s46, s43
    s_add_u32 s46, s46, 327680
    v_add_f32_dpp v40, v76, v72 row_ror:8 row_mask:0xf bank_mask:0x3
    v_add_f32_dpp v40, v80, v84 row_ror:8 row_mask:0xf bank_mask:0xc
    v_add_f32_dpp v41, v77, v73 row_ror:8 row_mask:0xf bank_mask:0x3
    v_add_f32_dpp v41, v81, v85 row_ror:8 row_mask:0xf bank_mask:0xc
    v_add_f32_dpp v42, v78, v74 row_ror:8 row_mask:0xf bank_mask:0x3
    v_add_f32_dpp v42, v82, v86 row_ror:8 row_mask:0xf bank_mask:0xc
    v_add_f32_dpp v43, v79, v75 row_ror:8 row_mask:0xf bank_mask:0x3
    v_add_f32_dpp v43, v83, v87 row_ror:8 row_mask:0xf bank_mask:0xc
    v_perm_b32 v44, v40, v43, s56
    v_perm_b32 v45, v41, v43, s57
    v_perm_b32 v46, v42, v43, s58
    v_mov_b32 v47, s59
    buffer_store_dwordx4 v[44:47], v33, s[36:39], s42 offen sc1
    s_cmp_lg_u32 s5, 0
    s_cbranch_scc1 L_go
    s_mov_b64 exec, 0xff
    buffer_store_dwordx4 v[28:31], v113, s[36:39], s46 offen sc1
    s_mov_b64 exec, -1
L_go:
    s_lshl_b32 s42, s14, 14
    s_lshl_b32 s43, s5, 12
    s_add_u32 s42, s42, s43
    s_add_u32 s42, s42, 360448
    s_lshl_b32 s46, s49, 13
    s_and_b32 s43, s14, 14
    s_lshl_b32 s43, s43, 3
    s_add_u32 s46, s46, s43
    s_add_u32 s46, s46, 327680
    v_lshl_add_u32 v49, v7, 2, v4
    s_lshl_b32 s43, s5, 4
    v_add_u32 v50, s43, v49
    v_and_b32 v50, 63, v50
    v_lshlrev_b32 v50, 7, v50
    v_lshl_add_u32 v49, v49, 2, v126
    s_mov_b32 s62, 200000
W30:
    ds_read_b32 v127, v126 offset:0
    s_waitcnt lgkmcnt(0)
    v_readfirstlane_b32 s63, v127
    s_sub_u32 s62, s62, 1
    s_cbranch_scc1 E31
    s_cmp_lt_i32 s63, 160
    s_cbranch_scc1 W30
E31:
    buffer_load_dwordx4 v[24:27], v50, s[36:39], s46 offen
    buffer_load_dwordx4 v[28:31], v113, s[36:39], s42 offen offset:0
    buffer_load_dwordx4 v[32:35], v113, s[36:39], s42 offen offset:1024
    buffer_load_dwordx4 v[36:39], v113, s[36:39], s42 offen offset:2048
    buffer_load_dwordx4 v[40:43], v113, s[36:39], s42 offen offset:3072
    v_xor_b32 v111, 32, v112
    s_and_b32 s15, s5, 3
    s_lshl_b32 s15, s15, 6
    s_lshr_b32 s43, s5, 2
    s_lshl_b32 s43, s43, 10
    s_add_u32 s43, s43, 101376
    v_add3_u32 v116, v112, v122, s43
    v_add3_u32 v115, v111, v122, s43
    s_lshl_b32 s47, s13, 3
L_pad9:
    s_cbranch_execz L_end
    s_add_u32 s47, s47, s5
    s_lshl_b32 s47, s47, 13
    s_lshl_b32 s43, s14, 7
    s_add_u32 s47, s47, s43
    s_add_u32 s47, s47, 1409024
    v_and_b32 v52, 1, v0
    v_lshl_add_u32 v52, v52, 6, v117
    s_lshl_b32 s15, s15, 1
    s_add_u32 s15, s15, 137728
    v_add_u32 v52, s15, v52
    v_mov_b32 v72, 0
    v_mov_b32 v73, 0
    v_mov_b32 v74, 0
    v_mov_b32 v75, 0
    s_mov_b32 s62, 200000
W34:
    ds_read_b32 v127, v126 offset:0
    s_waitcnt lgkmcnt(0)
    v_readfirstlane_b32 s63, v127
    s_sub_u32 s62, s62, 1
    s_cbranch_scc1 E35
    s_cmp_lt_i32 s63, 160
    s_cbranch_scc1 W34
E35:
    ds_read_b64_tr_b16 v[56:57], v116 offset:0
    ds_read_b64_tr_b16 v[58:59], v116 offset:8320
    ds_read_b64_tr_b16 v[60:61], v116 offset:16640
    ds_read_b64_tr_b16 v[62:63], v116 offset:24960
    ds_read_b64_tr_b16 v[64:65], v115 offset:0
    ds_read_b64_tr_b16 v[66:67], v115 offset:8320
    ds_read_b64_tr_b16 v[68:69], v115 offset:16640
    ds_read_b64_tr_b16 v[70:71], v115 offset:24960
    s_cmp_ge_u32 s4, 28
    s_cbranch_scc1 L_nc
    s_mov_b32 s62, 200000
W36:
    ds_read_b32 v127, v126 offset:20
    s_waitcnt lgkmcnt(0)
    v_readfirstlane_b32 s63, v127
    s_sub_u32 s62, s62, 1
    s_cbranch_scc1 E37
    s_cmp_lt_i32 s63, 4
    s_cbranch_scc1 W36
E37:
    ds_read_b128 v[72:75], v52
L_nc:
    s_mov_b32 s62, 200000
G32:
    s_waitcnt vmcnt(4)
    v_cmp_ne_u32 s[18:19], s59, v27
    s_waitcnt vmcnt(3)
    v_cmp_ne_u32 s[20:21], s59, v31
    s_waitcnt vmcnt(2)
    v_cmp_ne_u32 s[22:23], s59, v35
    s_waitcnt vmcnt(1)
    v_cmp_ne_u32 s[24:25], s59, v39
    s_waitcnt vmcnt(0)
    v_cmp_ne_u32 s[26:27], s59, v43
    s_or_b64 s[54:55], s[18:19], s[20:21]
    s_or_b64 s[54:55], s[54:55], s[22:23]
    s_or_b64 s[54:55], s[54:55], s[24:25]
    s_or_b64 s[54:55], s[54:55], s[26:27]
    s_cbranch_scc0 E33
    s_mov_b64 exec, s[18:19]
    buffer_load_dwordx4 v[24:27], v50, s[36:39], s46 offen sc1
    s_mov_b64 exec, s[20:21]
    buffer_load_dwordx4 v[28:31], v113, s[36:39], s42 offen offset:0 sc1
    s_mov_b64 exec, s[22:23]
    buffer_load_dwordx4 v[32:35], v113, s[36:39], s42 offen offset:1024 sc1
    s_mov_b64 exec, s[24:25]
    buffer_load_dwordx4 v[36:39], v113, s[36:39], s42 offen offset:2048 sc1
    s_mov_b64 exec, s[26:27]
    buffer_load_dwordx4 v[40:43], v113, s[36:39], s42 offen offset:3072 sc1
    s_mov_b64 exec, -1
    s_sub_u32 s62, s62, 1
    s_cbranch_scc0 G32
    s_waitcnt vmcnt(0)
E33:
    v_max_f32_dpp v26, v24, v24 quad_perm:[1,0,3,2] row_mask:0xf bank_mask:0xf
    v_perm_b32 v31, v29, v28, s60
    v_perm_b32 v31, v30, v31, s61
    v_max_f32_dpp v26, v26, v26 quad_perm:[2,3,0,1] row_mask:0xf bank_mask:0xf
    v_perm_b32 v35, v33, v32, s60
    v_perm_b32 v35, v34, v35, s61
    v_max_f32_dpp v26, v26, v26 row_ror:4 row_mask:0xf bank_mask:0xf
    v_perm_b32 v39, v37, v36, s60
    v_perm_b32 v39, v38, v39, s61
    v_max_f32_dpp v26, v26, v26 row_ror:8 row_mask:0xf bank_mask:0xf
    v_perm_b32 v43, v41, v40, s60
    v_perm_b32 v43, v42, v43, s61
    v_mov_b32 v27, v26
    s_nop 1
    v_permlane16_swap_b32 v26, v27
    s_nop 1
    v_max_f32 v26, v26, v27
    v_mov_b32 v27, v26
    s_nop 1
    v_permlane32_swap_b32 v26, v27
    s_nop 1
    v_max_f32 v26, v26, v27
    v_sub_f32 v24, v24, v26
    v_exp_f32 v24, v24
    s_nop 0
L_pad10:
    s_cbranch_execz L_pad11
    v_mul_f32 v25, v24, v25
    s_nop 0
    v_mul_f32_dpp v28, v24, v28 row_newbcast:0 row_mask:0xf bank_mask:0xf
    v_mul_f32_dpp v29, v24, v29 row_newbcast:0 row_mask:0xf bank_mask:0xf
    v_mul_f32_dpp v30, v24, v30 row_newbcast:0 row_mask:0xf bank_mask:0xf
    v_mul_f32_dpp v31, v24, v31 row_newbcast:0 row_mask:0xf bank_mask:0xf
    v_add_f32_dpp v25, v25, v25 quad_perm:[1,0,3,2] row_mask:0xf bank_mask:0xf
    v_fmac_f32_dpp v28, v24, v32 row_newbcast:1 row_mask:0xf bank_mask:0xf
    v_fmac_f32_dpp v29, v24, v33 row_newbcast:1 row_mask:0xf bank_mask:0xf
    v_fmac_f32_dpp v30, v24, v34 row_newbcast:1 row_mask:0xf bank_mask:0xf
    v_fmac_f32_dpp v31, v24, v35 row_newbcast:1 row_mask:0xf bank_mask:0xf
    v_add_f32_dpp v25, v25, v25 quad_perm:[2,3,0,1] row_mask:0xf bank_mask:0xf
    v_fmac_f32_dpp v28, v24, v36 row_newbcast:2 row_mask:0xf bank_mask:0xf
    v_fmac_f32_dpp v29, v24, v37 row_newbcast:2 row_mask:0xf bank_mask:0xf
    v_fmac_f32_dpp v30, v24, v38 row_newbcast:2 row_mask:0xf bank_mask:0xf
    v_fmac_f32_dpp v31, v24, v39 row_newbcast:2 row_mask:0xf bank_mask:0xf
    v_add_f32_dpp v25, v25, v25 row_ror:4 row_mask:0xf bank_mask:0xf
    v_fmac_f32_dpp v28, v24, v40 row_newbcast:3 row_mask:0xf bank_mask:0xf
    v_fmac_f32_dpp v29, v24, v41 row_newbcast:3 row_mask:0xf bank_mask:0xf
    v_fmac_f32_dpp v30, v24, v42 row_newbcast:3 row_mask:0xf bank_mask:0xf
    v_fmac_f32_dpp v31, v24, v43 row_newbcast:3 row_mask:0xf bank_mask:0xf
    v_add_f32_dpp v25, v25, v25 row_ror:8 row_mask:0xf bank_mask:0xf
    v_mov_b32 v26, v25
    v_permlane32_swap_b32 v28, v30
    v_permlane32_swap_b32 v29, v31
    v_permlane32_swap_b32 v25, v26
    v_pk_add_f32 v[28:29], v[28:29], v[30:31]
    v_add_f32 v25, v25, v26
    v_mov_b32 v26, v25
    v_permlane16_swap_b32 v28, v29
    s_nop 0
    v_permlane16_swap_b32 v25, v26
    v_add_f32 v28, v28, v29
    v_add_f32 v25, v25, v26
    v_rcp_f32 v25, v25
    s_nop 0
    v_mul_f32 v28, v28, v25
    ds_add_f32 v49, v28 offset:64
    s_mov_b64 exec, 1
    ds_add_u32 v126, v125 offset:16
    s_mov_b64 exec, -1
    v_mov_b32 v40, 0
    v_mov_b32 v41, 0
    v_mov_b32 v42, 0
    v_mov_b32 v43, 0
    v_mov_b32 v44, 0
    v_mov_b32 v45, 0
    v_mov_b32 v46, 0
    v_mov_b32 v47, 0
    s_branch L_wo2
L_wo:
    v_xor_b32 v111, 32, v112
    s_and_b32 s15, s5, 3
    s_lshl_b32 s15, s15, 6
    s_lshr_b32 s43, s5, 2
    s_lshl_b32 s43, s43, 10
    s_add_u32 s43, s43, 101376
    v_add3_u32 v116, v112, v122, s43
    v_add3_u32 v115, v111, v122, s43
    s_lshl_b32 s47, s13, 3
    s_add_u32 s47, s47, s5
    s_lshl_b32 s47, s47, 13
    s_lshl_b32 s43, s14, 7
    s_add_u32 s47, s47, s43
    s_add_u32 s47, s47, 1409024
    v_mov_b32 v72, 0
    v_mov_b32 v73, 0
    v_mov_b32 v74, 0
    v_mov_b32 v75, 0
    s_mov_b32 s62, 200000
W38:
    ds_read_b32 v127, v126 offset:0
    s_waitcnt lgkmcnt(0)
    v_readfirstlane_b32 s63, v127
    s_sub_u32 s62, s62, 1
    s_cbranch_scc1 E39
    s_cmp_lt_i32 s63, 160
    s_cbranch_scc1 W38
E39:
    ds_read_b64_tr_b16 v[56:57], v116 offset:0
    ds_read_b64_tr_b16 v[58:59], v116 offset:8320
    ds_read_b64_tr_b16 v[60:61], v116 offset:16640
    ds_read_b64_tr_b16 v[62:63], v116 offset:24960
    ds_read_b64_tr_b16 v[64:65], v115 offset:0
    ds_read_b64_tr_b16 v[66:67], v115 offset:8320
    ds_read_b64_tr_b16 v[68:69], v115 offset:16640
    ds_read_b64_tr_b16 v[70:71], v115 offset:24960
L_wo2:
    s_mov_b32 s62, 200000
W40:
    ds_read_b32 v127, v126 offset:16
    s_waitcnt lgkmcnt(0)
    v_readfirstlane_b32 s63, v127
    s_sub_u32 s62, s62, 1
    s_cbranch_scc1 E41
    s_cmp_lt_i32 s63, 4
    s_cbranch_scc1 W40
E41:
    ds_read_b128 v[8:11], v118 offset:3136
    ds_read_b128 v[12:15], v118 offset:3200
L_pad11:
    s_cbranch_execz L_end
    ds_read_b128 v[16:19], v118 offset:3264
    ds_read_b128 v[20:23], v118 offset:3328
    s_waitcnt lgkmcnt(1)
    v_cvt_pk_bf16_f32 v8, v8, v9
    v_cvt_pk_bf16_f32 v9, v10, v11
    v_cvt_pk_bf16_f32 v10, v12, v13
    v_cvt_pk_bf16_f32 v11, v14, v15
    v_cvt_pk_bf16_f32 v12, v16, v17
    v_cvt_pk_bf16_f32 v13, v18, v19
    s_waitcnt lgkmcnt(0)
    v_cvt_pk_bf16_f32 v14, v20, v21
    v_cvt_pk_bf16_f32 v15, v22, v23
    v_mfma_f32_16x16x32_bf16 v[40:43], v[56:59], v[8:11], v[40:43]
    v_mfma_f32_16x16x32_bf16 v[44:47], v[64:67], v[8:11], v[44:47]
    v_mfma_f32_16x16x32_bf16 v[40:43], v[60:63], v[12:15], v[40:43]
    v_mfma_f32_16x16x32_bf16 v[44:47], v[68:71], v[12:15], v[44:47]
    v_cmp_eq_u32 vcc, 1, v7
    s_nop 7
    v_cndmask_b32 v40, v40, v44, vcc
    v_cndmask_b32 v41, v41, v45, vcc
    v_cndmask_b32 v42, v42, v46, vcc
    v_cndmask_b32 v43, v43, v47, vcc
    v_pk_add_f32 v[40:41], v[40:41], v[72:73]
    v_pk_add_f32 v[42:43], v[42:43], v[74:75]
    v_perm_b32 v44, v40, v43, s56
    v_perm_b32 v45, v41, v43, s57
    v_perm_b32 v46, v42, v43, s58
    v_mov_b32 v47, s59
    s_mov_b32 s44, 0x00030003
    s_mov_b32 s45, 0x00030003
    s_mov_b64 exec, s[44:45]
    buffer_store_dwordx4 v[44:47], v114, s[36:39], s47 offen sc1
    s_mov_b64 exec, -1
    s_cmp_lt_u32 s4, 28
    s_cbranch_scc1 L_fin
    s_lshl_b32 s42, s3, 2
    s_add_u32 s42, s42, s4
    s_sub_u32 s42, s42, 28
    s_lshl_b32 s43, s42, 6
    s_lshl_b32 s44, s5, 3
    s_add_u32 s43, s43, s44
    s_lshl_b32 s46, s42, 13
    s_lshl_b32 s44, s5, 4
    s_add_u32 s46, s46, s44
    s_add_u32 s46, s46, 1409024
    v_lshlrev_b32 v48, 7, v0
    v_lshl_add_u32 v49, v4, 1, s43
    global_load_ushort v52, v49, s[16:17]
    buffer_load_dwordx4 v[24:27], v48, s[36:39], s46 offen sc1
    s_mov_b32 s62, 200000
G42:
    s_waitcnt vmcnt(0)
    v_cmp_ne_u32 s[18:19], s59, v27
    s_cmp_lg_u64 s[18:19], 0
    s_cbranch_scc0 E43
    s_mov_b64 exec, s[18:19]
    buffer_load_dwordx4 v[24:27], v48, s[36:39], s46 offen sc1
    s_mov_b64 exec, -1
    s_sub_u32 s62, s62, 1
    s_cbranch_scc0 G42
    s_waitcnt vmcnt(0)
E43:
    v_perm_b32 v27, v25, v24, s60
    v_perm_b32 v27, v26, v27, s61
    s_nop 1
    v_permlane32_swap_b32 v24, v26
    v_permlane32_swap_b32 v25, v27
    s_nop 1
    v_pk_add_f32 v[24:25], v[24:25], v[26:27]
    s_nop 1
    v_permlane16_swap_b32 v24, v25
    s_nop 1
    v_add_f32 v24, v24, v25
    s_nop 1
    v_add_f32_dpp v24, v24, v24 quad_perm:[1,0,3,2] row_mask:0xf bank_mask:0xf
    s_nop 1
    v_add_f32_dpp v24, v24, v24 quad_perm:[2,3,0,1] row_mask:0xf bank_mask:0xf
    s_nop 1
    v_add_f32_dpp v24, v24, v24 row_half_mirror row_mask:0xf bank_mask:0xf
    s_nop 1
    v_add_f32_dpp v24, v24, v24 row_mirror row_mask:0xf bank_mask:0xf
    v_lshlrev_b32 v52, 16, v52
    v_add_f32 v24, v24, v52
    v_cvt_pk_bf16_f32 v24, v24, v24
    s_mov_b32 s44, 0x00010001
    s_mov_b32 s45, 0x00010001
    s_mov_b64 exec, s[44:45]
    global_store_short v49, v24, s[40:41]
    s_mov_b64 exec, -1
    s_or_b32 s44, s42, s5
    s_cmp_lg_u32 s44, 0
    s_cbranch_scc1 L_fin
    v_mov_b32 v24, s51
    v_mov_b32 v25, 0
    s_mov_b64 exec, 1
    buffer_store_dword v24, v25, s[36:39], 0 offen sc1
    s_mov_b64 exec, -1
    s_branch L_fin
L_fin:
    s_endpgm
.section .rodata,"a"
.p2align 6
.amdhsa_kernel parallel_sum__sliding_block_cached__dense_activation_silu__decode_kernel
  .amdhsa_next_free_vgpr 128
  .amdhsa_next_free_sgpr 102
  .amdhsa_accum_offset 128
  .amdhsa_group_segment_fixed_size 0
  .amdhsa_kernarg_size 88
  .amdhsa_user_sgpr_count 2
  .amdhsa_user_sgpr_kernarg_segment_ptr 1
  .amdhsa_system_sgpr_workgroup_id_x 1
.end_amdhsa_kernel
```
